```python
import torch

def _softmax(x, axis=-1):
    return torch.softmax(x, dim=axis)
def _gelu(x):
    return torch.nn.functional.gelu(x, approximate="tanh")
def _silu(x):
    return torch.nn.functional.silu(x)
def _sigmoid(x):
    return torch.sigmoid(x)
def _layernorm(x, axis=-1, eps=1e-5):
    m = x.mean(dim=axis, keepdim=True)
    v = x.var(dim=axis, keepdim=True, unbiased=False)
    return (x - m) / torch.sqrt(v + eps)
def _scatter_add(tgt, idx, src, axis=0):
    return tgt.clone().index_add_(axis, idx, src)
def _segment_sum(src, seg, n):
    out = torch.zeros((n,) + src.shape[1:], dtype=src.dtype)
    return out.index_add_(0, seg, src)
def _pad(x, pw):
    flat = tuple(v for pair in reversed(pw) for v in pair)
    return torch.nn.functional.pad(x, flat)

kernel_name = 'sequential_preLN__sliding_block_cached__dense_activation_squared_relu__decode'

def setup_inputs():

    _w = (lambda a: (lambda t: t.to(torch.bfloat16) if t.is_floating_point() else t)(torch.as_tensor(a)))
    def _A_setup():
        B, Sq, D = 1, 1, 512
        Hq, Hkv, Sk, Dh = 32, 32, 4096, 128
        assert Hq % Hkv == 0, (Hq, Hkv)
        return {
            "x": _w((lambda *s: torch.randn(*s, dtype=torch.bfloat16) * 0.05)(B, Sq, D)),
            "k_cache": _w((lambda *s: torch.randn(*s, dtype=torch.bfloat16) * 3.2)(B, Hkv, Sk, Dh)),
            "v_cache": _w((lambda *s: torch.randn(*s, dtype=torch.bfloat16) * 0.4)(B, Hkv, Sk, Dh)),
            "wq": _w((lambda *s: torch.randn(*s, dtype=torch.bfloat16) * 3.2)(D, Hq * Dh) * (D ** -0.5)),
            "wo": _w((lambda *s: torch.randn(*s, dtype=torch.bfloat16) * 0.4)(Hq * Dh, D) * ((Hq * Dh) ** -0.5)),
        }
    _A_in = _A_setup()

    def _B_setup():
        B, S, D, F = 1, 1, 512, 1376
        return {
            "x": _w((lambda *s: torch.randn(*s, dtype=torch.bfloat16) * 0.05)(B, S, D)),
            "w1": _w((lambda *s: torch.randn(*s, dtype=torch.bfloat16) * 0.05)(D, F)),
            "b1": _w((lambda *s: torch.randn(*s, dtype=torch.bfloat16) * 0.4)(F)),
            "w2": _w((lambda *s: torch.randn(*s, dtype=torch.bfloat16) * 0.05)(F, D)),
            "b2": _w((lambda *s: torch.randn(*s, dtype=torch.bfloat16) * 1.6)(D)),
        }
    _B_in = _B_setup()

    return {
        "A_x": _A_in["x"],
        "A_k_cache": _A_in["k_cache"],
        "A_v_cache": _A_in["v_cache"],
        "A_wq": _A_in["wq"],
        "A_wo": _A_in["wo"],
        "B_x": _B_in["x"],
        "B_w1": _B_in["w1"],
        "B_b1": _B_in["b1"],
        "B_w2": _B_in["w2"],
        "B_b2": _B_in["b2"],
    }

def reference(A_x, A_k_cache, A_v_cache, A_wq, A_wo, B_x, B_w1, B_b1, B_w2, B_b2):
    def _A_ref(x, k_cache, v_cache, wq, wo):
        B, Sq, D = x.shape
        Hq, Dh = 32, 128
        Hkv, Sk = k_cache.shape[1], k_cache.shape[2]
        W = min(4096, max(256, Sk // 4))
        rep = Hq // Hkv
        q = (lambda x, *d: x.permute(*d))((x @ wq).reshape(B, Sq, Hq, Dh), 0, 2, 1, 3)
        k = (lambda x, n, axis: torch.repeat_interleave(x, n, dim=axis))(k_cache[:, :, Sk - W:, :], rep, axis=1)
        v = (lambda x, n, axis: torch.repeat_interleave(x, n, dim=axis))(v_cache[:, :, Sk - W:, :], rep, axis=1)
        scores = torch.einsum("bhqd,bhkd->bhqk", q, k) * (Dh ** -0.5)
        p = _softmax(scores, axis=-1)
        o = torch.einsum("bhqk,bhkd->bhqd", p, v)
        return (lambda x, *d: x.permute(*d))(o, 0, 2, 1, 3).reshape(B, Sq, Hq * Dh) @ wo

    def _B_ref(x, w1, b1, w2, b2):
        h = torch.einsum("bsd,df->bsf", x, w1) + b1
        zero = torch.zeros_like(h)
        r = torch.where(h > zero, h, zero)
        h = r * r
        out = torch.einsum("bsf,fd->bsd", h, w2) + b2
        return out

    x = A_x
    h = x + _A_ref(_layernorm(x, axis=-1), A_k_cache, A_v_cache, A_wq, A_wo)
    h2 = h + _B_ref(_layernorm(h, axis=-1), B_w1, B_b1, B_w2, B_b2)
    return h2
```

```asm
; @launch grid=(256,1,1) block=(512,1,1) lds=81920
.amdgcn_target "amdgcn-amd-amdhsa--gfx950"
.text
.globl sequential_preLN__sliding_block_cached__dense_activation_squared_relu__decode_kernel
.p2align 12
.type sequential_preLN__sliding_block_cached__dense_activation_squared_relu__decode_kernel,@function
sequential_preLN__sliding_block_cached__dense_activation_squared_relu__decode_kernel:
  s_cmp_ge_u32 s2, 256
  s_cbranch_scc1 END
  s_load_dwordx16 s[8:23], s[0:1], 0
  s_load_dwordx2 s[32:33], s[0:1], 96
  s_load_dwordx8 s[24:31], s[0:1], 64
  s_lshr_b32 s39, s2, 3
  s_and_b32 s40, s39, 3
  s_getpc_b64 s[54:55]
  s_lshl_b32 s41, s40, 7
  s_add_u32 s54, s54, s41
  s_addc_u32 s55, s55, 0
  v_lshlrev_b32 v10, 9, v0
  v_mov_b32 v11, s55
  v_add_co_u32 v10, vcc, s54, v10
  v_addc_co_u32 v11, vcc, 0, v11, vcc
  v_cmp_gt_u32 vcc, 18, v0
  s_and_saveexec_b64 s[56:57], vcc
  s_cbranch_execz NOPF
  global_load_dword v30, v[10:11], off
NOPF:
  s_mov_b64 exec, -1
  v_lshrrev_b32 v8, 6, v0
  v_and_b32 v1, 63, v0
  v_readfirstlane_b32 s35, v8
  s_and_b32 s38, s2, 7
  s_lshl_b32 s36, s38, 2
  s_add_u32 s36, s36, s40
  s_lshr_b32 s37, s39, 2
  v_lshlrev_b32 v9, 4, v1
  s_mul_i32 s41, s37, 3
  s_cmp_eq_u32 s37, 7
  s_cselect_b32 s41, 25, s41
  s_lshl_b32 s41, s41, 3
  s_add_u32 s41, s41, s35
  s_lshl_b32 s41, s41, 10
  s_lshl_b32 s42, s36, 20
  s_add_u32 s41, s41, s42
  s_add_u32 s41, s41, 0xC0000
  v_add_u32 v13, s41, v9
  v_mov_b32 v12, v13
  v_lshrrev_b32 v2, 4, v1
  v_and_b32 v3, 15, v1
  s_cmp_lt_u32 s37, 4
  s_cbranch_scc0 F_NQ
  s_lshr_b32 s40, s37, 1
  s_lshl_b32 s40, s40, 3
  s_add_u32 s40, s40, s35
  s_lshl_b32 s40, s40, 5
  v_lshrrev_b32 v10, 3, v1
  v_lshl_add_u32 v10, v10, 2, s40
  s_lshl_b32 s41, s36, 1
  s_and_b32 s42, s37, 1
  s_add_u32 s41, s41, s42
  s_lshl_b32 s41, s41, 7
  v_and_b32 v11, 0x70, v9
  v_lshl_add_u32 v11, v10, 13, v11
  v_add_u32 v11, s41, v11
  v_lshlrev_b32 v10, 1, v10
  s_waitcnt lgkmcnt(0)
  global_load_dwordx4 v[16:19], v9, s[8:9]
  global_load_dwordx2 v[24:25], v10, s[8:9]
  global_load_dwordx4 v[64:67], v11, s[14:15] nt
  v_add_u32 v11, 0x2000, v11
  global_load_dwordx4 v[68:71], v11, s[14:15] nt
  v_add_u32 v11, 0x2000, v11
  global_load_dwordx4 v[72:75], v11, s[14:15] nt
  v_add_u32 v11, 0x2000, v11
  global_load_dwordx4 v[76:79], v11, s[14:15] nt
  s_load_dword s34, s[32:33], 0
  s_lshl_b32 s40, s36, 2
  s_add_u32 s40, s40, s37
  s_lshl_b32 s54, s40, 11
  s_add_u32 s54, s54, 0x200000
  s_lshl_b32 s55, s40, 8
  s_add_u32 s55, s55, 0x1000
  v_lshlrev_b32 v10, 7, v3
  v_add_u32 v10, s54, v10
  s_cmp_lg_u32 s35, 0
  s_cbranch_scc1 NOTOUCH
  global_load_dword v29, v10, s[32:33]
NOTOUCH:
  s_branch F_C
F_NQ:
  s_waitcnt lgkmcnt(0)
  s_load_dword s34, s[32:33], 0
  s_and_b32 s40, s39, 15
  s_cmp_eq_u32 s35, 0
  s_cbranch_scc0 SPF1
  s_lshl_b32 s41, s38, 4
  s_add_u32 s41, s41, s40
  s_lshl_b32 s41, s41, 15
  s_add_u32 s41, s41, 0x180
  v_lshrrev_b32 v10, 1, v1
  v_lshlrev_b32 v10, 10, v10
  v_and_b32 v11, 1, v1
  v_lshl_add_u32 v10, v11, 6, v10
  v_add_u32 v10, s41, v10
  global_load_dword v29, v10, s[16:17]
SPF1:
  s_cmp_eq_u32 s35, 1
  s_cbranch_scc0 SPF2
  s_lshl_b32 s41, s38, 22
  s_mul_i32 s42, s40, 3072
  s_add_u32 s41, s41, s42
  s_and_b32 s42, s40, 8
  s_mul_i32 s42, s42, 3072
  s_add_u32 s41, s41, s42
  s_add_u32 s41, s41, 1859584
  v_min_u32 v10, 47, v1
  v_lshl_add_u32 v10, v10, 6, s41
  global_load_dword v29, v10, s[10:11]
SPF2:
  s_cmp_lt_u32 s37, 6
  s_cbranch_scc0 NLATE
  s_waitcnt lgkmcnt(0)
NLATE:
  global_load_dwordx4 v[112:115], v12, s[10:11] nt
  v_add_u32 v12, 0x2000, v12
  global_load_dwordx4 v[116:119], v12, s[10:11] nt
  v_add_u32 v12, 0x2000, v12
  global_load_dwordx4 v[120:123], v12, s[10:11] nt
  s_cmp_lt_u32 s37, 6
  s_cbranch_scc1 F_C
  v_add_u32 v12, 0x2000, v12
  global_load_dwordx4 v[96:99], v12, s[10:11] nt
  v_add_u32 v12, 0x2000, v12
  global_load_dwordx4 v[100:103], v12, s[10:11] nt
  v_add_u32 v12, 0x2000, v12
  global_load_dwordx4 v[104:107], v12, s[10:11] nt
  v_add_u32 v12, 0x2000, v12
  global_load_dwordx4 v[108:111], v12, s[10:11] nt
F_C:
  s_mov_b32 s48, 0xffff0000
  s_mov_b32 s50, 65536
  v_and_b32 v14, 1, v1
  v_lshlrev_b32 v14, 4, v14
  v_mov_b32 v15, 0xffff
  v_lshlrev_b32 v14, v14, v15
  v_bfe_u32 v15, v1, 1, 2
  v_cmp_eq_u32 vcc, 0, v15
  s_nop 1
  v_cndmask_b32 v4, 0, v14, vcc
  v_cmp_eq_u32 vcc, 1, v15
  s_nop 1
  v_cndmask_b32 v5, 0, v14, vcc
  v_cmp_eq_u32 vcc, 2, v15
  s_nop 1
  v_cndmask_b32 v6, 0, v14, vcc
  v_cmp_eq_u32 vcc, 3, v15
  s_nop 1
  v_cndmask_b32 v7, 0, v14, vcc
  v_and_b32 v14, 1, v2
  v_lshlrev_b32 v14, 4, v14
  v_lshl_add_u32 v14, v3, 5, v14
  v_mov_b32 v8, 0xff
  v_mov_b32 v26, v14
  s_lshl_b32 s40, s35, 9
  s_lshr_b32 s41, s35, 2
  s_lshl_b32 s42, s41, 7
  s_add_u32 s40, s40, s42
  v_add_u32 v14, s40, v14
  s_movk_i32 s43, 0x880
  s_mov_b64 s[100:101], s[12:13]
  v_and_b32 v10, 3, v1
  v_lshl_add_u32 v10, v2, 2, v10
  v_lshlrev_b32 v10, 5, v10
  v_and_b32 v15, 4, v1
  v_lshl_add_u32 v10, v15, 2, v10
  v_lshrrev_b32 v15, 3, v3
  v_mad_u32_u24 v15, v15, s43, v10
  s_lshl_b32 s40, s36, 3
  s_add_u32 s40, s40, s37
  s_lshl_b32 s52, s40, 9
  s_lshl_b32 s40, s36, 13
  s_bfe_u32 s41, s35, 0x10001
  s_lshl_b32 s41, s41, 11
  s_add_u32 s40, s40, s41
  s_and_b32 s41, s35, 1
  s_lshl_b32 s41, s41, 7
  s_add_u32 s40, s40, s41
  s_add_u32 s40, s40, 0x200000
  s_add_u32 s98, s32, s40
  s_addc_u32 s99, s33, 0
  v_lshlrev_b32 v20, 4, v3
  s_lshl_b32 s40, s35, 2
  s_add_u32 s40, s40, 4608
  v_mov_b32 v21, s40
  s_mov_b64 exec, 0
  s_cmp_eq_u32 s35, 0
  s_cbranch_scc1 PAD1_0
  s_cmp_eq_u32 s35, 1
  s_cbranch_scc1 PAD1_1
  s_cmp_eq_u32 s35, 2
  s_cbranch_scc1 PAD1_2
  s_cmp_eq_u32 s35, 3
  s_cbranch_scc1 PAD1_3
  s_cmp_eq_u32 s35, 4
  s_cbranch_scc1 PAD1_4
WB1:
  s_mov_b64 exec, -1
  s_cmp_lt_u32 s37, 4
  s_cbranch_scc0 F_D
  s_waitcnt vmcnt(5)
  v_lshlrev_b32 v48, 16, v16
  v_and_b32 v49, s48, v16
  v_lshlrev_b32 v50, 16, v17
  v_and_b32 v51, s48, v17
  v_lshlrev_b32 v52, 16, v18
  v_and_b32 v53, s48, v18
  v_lshlrev_b32 v54, 16, v19
  v_and_b32 v55, s48, v19
  v_pk_add_f32 v[56:57], v[48:49], v[50:51]
  v_pk_add_f32 v[58:59], v[52:53], v[54:55]
  v_pk_add_f32 v[56:57], v[56:57], v[58:59]
  v_add_f32 v56, v56, v57
  s_nop 1
  v_add_f32_dpp v56, v56, v56 row_ror:8 row_mask:0xf bank_mask:0xf
  s_nop 1
  v_add_f32_dpp v56, v56, v56 row_ror:4 row_mask:0xf bank_mask:0xf
  s_nop 1
  v_add_f32_dpp v56, v56, v56 row_ror:2 row_mask:0xf bank_mask:0xf
  s_nop 1
  v_add_f32_dpp v56, v56, v56 row_ror:1 row_mask:0xf bank_mask:0xf
  s_nop 1
  v_add_f32_dpp v56, v56, v56 row_bcast:15 row_mask:0xa bank_mask:0xf
  s_nop 1
  v_add_f32_dpp v56, v56, v56 row_bcast:31 row_mask:0xc bank_mask:0xf
  s_nop 0
  v_readlane_b32 s40, v56, 63
  v_mov_b32 v60, 0x3b000000
  s_nop 0
  v_mul_f32 v62, s40, v60
  v_pk_add_f32 v[48:49], v[48:49], v[62:63] op_sel_hi:[1,0] neg_lo:[0,1] neg_hi:[0,1]
  v_pk_add_f32 v[50:51], v[50:51], v[62:63] op_sel_hi:[1,0] neg_lo:[0,1] neg_hi:[0,1]
  v_pk_add_f32 v[52:53], v[52:53], v[62:63] op_sel_hi:[1,0] neg_lo:[0,1] neg_hi:[0,1]
  v_pk_add_f32 v[54:55], v[54:55], v[62:63] op_sel_hi:[1,0] neg_lo:[0,1] neg_hi:[0,1]
  v_pk_mul_f32 v[56:57], v[48:49], v[48:49]
  v_pk_fma_f32 v[56:57], v[50:51], v[50:51], v[56:57]
  v_pk_fma_f32 v[56:57], v[52:53], v[52:53], v[56:57]
  v_pk_fma_f32 v[56:57], v[54:55], v[54:55], v[56:57]
  v_add_f32 v56, v56, v57
  s_nop 1
  v_add_f32_dpp v56, v56, v56 row_ror:8 row_mask:0xf bank_mask:0xf
  s_nop 1
  v_add_f32_dpp v56, v56, v56 row_ror:4 row_mask:0xf bank_mask:0xf
  s_nop 1
  v_add_f32_dpp v56, v56, v56 row_ror:2 row_mask:0xf bank_mask:0xf
  s_nop 1
  v_add_f32_dpp v56, v56, v56 row_ror:1 row_mask:0xf bank_mask:0xf
  s_nop 1
  v_add_f32_dpp v56, v56, v56 row_bcast:15 row_mask:0xa bank_mask:0xf
  s_nop 1
  v_add_f32_dpp v56, v56, v56 row_bcast:31 row_mask:0xc bank_mask:0xf
  s_nop 0
  v_readlane_b32 s40, v56, 63
  v_cvt_pk_bf16_f32 v57, 0, v62
  s_nop 0
  v_mul_f32 v58, s40, v60
  v_cvt_pk_bf16_f32 v58, 0, v58
  v_add_f32 v58, 0x3727c5ac, v58
  v_cvt_pk_bf16_f32 v58, 0, v58
  v_sqrt_f32 v58, v58
  s_nop 0
  v_cvt_pk_bf16_f32 v58, 0, v58
  v_rcp_f32 v58, v58
  s_waitcnt vmcnt(4)
  v_lshlrev_b32 v48, 16, v24
  v_and_b32 v49, s48, v24
  v_lshlrev_b32 v50, 16, v25
  v_and_b32 v51, s48, v25
  v_sub_f32 v48, v48, v57
  v_sub_f32 v49, v49, v57
  v_sub_f32 v50, v50, v57
  v_sub_f32 v51, v51, v57
  v_cvt_pk_bf16_f32 v48, 0, v48
  v_cvt_pk_bf16_f32 v49, 0, v49
  v_cvt_pk_bf16_f32 v50, 0, v50
  v_cvt_pk_bf16_f32 v51, 0, v51
  v_mul_f32 v48, v48, v58
  v_mul_f32 v49, v49, v58
  v_mul_f32 v50, v50, v58
  v_mul_f32 v51, v51, v58
  v_cvt_pk_bf16_f32 v48, v48, v48
  v_cvt_pk_bf16_f32 v49, v49, v49
  v_cvt_pk_bf16_f32 v50, v50, v50
  v_cvt_pk_bf16_f32 v51, v51, v51
  v_and_b32 v32, v48, v4
  v_and_b32 v33, v48, v5
  v_and_b32 v34, v48, v6
  v_and_b32 v35, v48, v7
  v_and_b32 v36, v49, v4
  v_and_b32 v37, v49, v5
  v_and_b32 v38, v49, v6
  v_and_b32 v39, v49, v7
  v_and_b32 v40, v50, v4
  v_and_b32 v41, v50, v5
  v_and_b32 v42, v50, v6
  v_and_b32 v43, v50, v7
  v_and_b32 v44, v51, v4
  v_and_b32 v45, v51, v5
  v_and_b32 v46, v51, v6
  v_and_b32 v47, v51, v7
  s_lshl_b32 s40, s35, 9
  s_lshr_b32 s41, s35, 1
  s_lshl_b32 s41, s41, 6
  s_add_u32 s40, s40, s41
  v_add_u32 v10, s40, v26
  v_bfe_u32 v11, v1, 2, 2
  v_and_b32 v16, 0x30, v9
  v_lshl_add_u32 v16, v2, 6, v16
  v_lshl_add_u32 v17, v11, 8, v16
  v_add_u32 v17, s54, v17
  v_add_u32 v18, s55, v16
  v_mul_u32_u24 v11, 0x440, v11
  v_add_u32 v11, v11, v16
  s_mov_b32 s40, 0x00ff00ff
  s_mov_b32 s41, 0xff00ff00
  s_waitcnt vmcnt(3)
  v_mfma_f32_16x16x32_bf16 v[48:51], v[32:35], v[64:67], 0
  s_waitcnt vmcnt(2)
  v_mfma_f32_16x16x32_bf16 v[48:51], v[36:39], v[68:71], v[48:51]
  s_waitcnt vmcnt(1)
  v_mfma_f32_16x16x32_bf16 v[48:51], v[40:43], v[72:75], v[48:51]
  s_waitcnt vmcnt(0)
  v_mfma_f32_16x16x32_bf16 v[48:51], v[44:47], v[76:79], v[48:51]
  s_mov_b64 exec, s[40:41]
  s_nop 6
  ds_write_b128 v10, v[48:51] offset:0
  s_mov_b64 exec, -1
  s_waitcnt lgkmcnt(0)
  s_cmp_lg_u32 s35, 7
  s_barrier
  s_cbranch_scc1 L_A
  ds_read_b128 v[48:51], v11 offset:0
  ds_read_b128 v[52:55], v11 offset:256
  ds_read_b128 v[56:59], v11 offset:512
  ds_read_b128 v[60:63], v11 offset:768
  s_add_u32 s42, s34, 0x9e3779b1
  s_and_b32 s44, s42, 0xff
  s_bfe_u32 s45, s42, 0x80008
  s_bfe_u32 s46, s42, 0x80010
  s_lshr_b32 s47, s42, 24
  s_mov_b32 s40, 0x000f000f
  s_mov_b32 s41, s40
  s_waitcnt lgkmcnt(2)
  v_pk_add_f32 v[48:49], v[48:49], v[52:53]
  v_pk_add_f32 v[50:51], v[50:51], v[54:55]
  s_waitcnt lgkmcnt(0)
  v_pk_add_f32 v[56:57], v[56:57], v[60:61]
  v_pk_add_f32 v[58:59], v[58:59], v[62:63]
  v_pk_add_f32 v[48:49], v[48:49], v[56:57]
  v_pk_add_f32 v[50:51], v[50:51], v[58:59]
  s_nop 0
  v_add_f32_dpp v48, v48, v48 row_ror:8 row_mask:0xf bank_mask:0xf
  v_add_f32_dpp v49, v49, v49 row_ror:8 row_mask:0xf bank_mask:0xf
  v_add_f32_dpp v50, v50, v50 row_ror:8 row_mask:0xf bank_mask:0xf
  v_add_f32_dpp v51, v51, v51 row_ror:8 row_mask:0xf bank_mask:0xf
  v_add_f32_dpp v48, v48, v48 row_ror:4 row_mask:0xf bank_mask:0xf
  v_add_f32_dpp v49, v49, v49 row_ror:4 row_mask:0xf bank_mask:0xf
  v_add_f32_dpp v50, v50, v50 row_ror:4 row_mask:0xf bank_mask:0xf
  v_add_f32_dpp v51, v51, v51 row_ror:4 row_mask:0xf bank_mask:0xf
  v_bfi_b32 v48, v8, s44, v48
  v_bfi_b32 v49, v8, s45, v49
  v_bfi_b32 v50, v8, s46, v50
  v_bfi_b32 v51, v8, s47, v51
  global_store_dwordx4 v17, v[48:51], s[32:33]
  global_store_dwordx4 v17, v[48:51], s[32:33] offset:1024
  s_mov_b64 exec, s[40:41]
  global_store_dwordx4 v18, v[48:51], s[32:33] sc1
  s_mov_b64 exec, -1
L_A:
  s_barrier
  global_load_dwordx4 v[112:115], v12, s[10:11] nt
  v_add_u32 v12, 0x2000, v12
  global_load_dwordx4 v[116:119], v12, s[10:11] nt
  v_add_u32 v12, 0x2000, v12
  global_load_dwordx4 v[120:123], v12, s[10:11] nt
F_D:
  v_mov_b32 v12, v13
  s_waitcnt lgkmcnt(0)
  s_add_u32 s34, s34, 0x9e3779b1
  s_and_b32 s44, s34, 0xff
  s_bfe_u32 s45, s34, 0x80008
  s_bfe_u32 s46, s34, 0x80010
  s_lshr_b32 s47, s34, 24
  s_cmp_lg_u32 s35, 7
  s_cbranch_scc1 NOPD
  s_not_b32 s40, s34
  v_mov_b32 v48, s40
  v_mov_b32 v49, s40
  v_mov_b32 v50, s40
  v_mov_b32 v51, s40
  s_add_u32 s42, s52, 0x40000
  v_add_u32 v10, s42, v9
  s_lshr_b32 s42, s52, 5
  s_add_u32 s42, s42, 0x30000
  v_mov_b32 v11, s42
  v_cmp_gt_u32 vcc, 32, v1
  s_nop 1
  v_cndmask_b32 v10, v11, v10, vcc
  s_mov_b32 exec_hi, 1
  global_store_dwordx4 v10, v[48:51], s[32:33]
  s_mov_b64 exec, -1
NOPD:
  s_mov_b32 s49, 7
  s_cmp_lt_u32 s37, 4
  s_cbranch_scc1 V_NQ
  s_barrier
  s_mov_b32 s51, 0
V_NQ:
  global_load_dwordx4 v[80:83], v12, s[100:101] nt
  v_add_u32 v12, 0x2000, v12
  global_load_dwordx4 v[84:87], v12, s[100:101] nt
  v_add_u32 v12, 0x2000, v12
  global_load_dwordx4 v[88:91], v12, s[100:101] nt
  s_cmp_lt_u32 s37, 4
  s_cbranch_scc1 FETCH
  s_cmp_lt_u32 s37, 6
  s_cbranch_scc0 V_A
  s_lshl_b32 s62, s35, 13
  s_add_u32 s62, s62, 16384
  s_lshr_b32 s40, s35, 2
  s_and_b32 s41, s35, 3
  s_lshl_b32 s42, s38, 19
  s_lshl_b32 s43, s40, 18
  s_add_u32 s42, s42, s43
  s_lshl_b32 s43, s41, 15
  s_add_u32 s42, s42, s43
  s_and_b32 s43, s39, 7
  s_lshl_b32 s43, s43, 7
  s_add_u32 s42, s42, s43
  v_lshrrev_b32 v16, 3, v1
  v_and_b32 v17, 0x70, v9
  v_lshl_add_u32 v16, v16, 10, v17
  v_add_u32 v16, s42, v16
  s_add_u32 m0, s62, 0
  s_nop 0
  global_load_lds_dwordx4 v16, s[16:17] nt
  s_add_u32 m0, s62, 1024
  v_xor_b32 v17, 0x2020, v16
  global_load_lds_dwordx4 v17, s[16:17] nt
  s_add_u32 m0, s62, 2048
  v_xor_b32 v17, 0x4040, v16
  global_load_lds_dwordx4 v17, s[16:17] nt
  s_add_u32 m0, s62, 3072
  v_xor_b32 v17, 0x6060, v16
  global_load_lds_dwordx4 v17, s[16:17] nt
  s_add_u32 m0, s62, 4096
  v_xor_b32 v17, 0x20000, v16
  global_load_lds_dwordx4 v17, s[16:17] nt
  s_add_u32 m0, s62, 5120
  v_xor_b32 v17, 0x22020, v16
  global_load_lds_dwordx4 v17, s[16:17] nt
  s_add_u32 m0, s62, 6144
  v_xor_b32 v17, 0x24040, v16
  global_load_lds_dwordx4 v17, s[16:17] nt
  s_add_u32 m0, s62, 7168
  v_xor_b32 v17, 0x26060, v16
  global_load_lds_dwordx4 v17, s[16:17] nt
  s_branch FETCH
V_A:
  v_add_u32 v12, 0x2000, v12
  global_load_dwordx4 v[64:67], v12, s[12:13] nt
  v_add_u32 v12, 0x2000, v12
  global_load_dwordx4 v[68:71], v12, s[12:13] nt
  v_add_u32 v12, 0x2000, v12
  global_load_dwordx4 v[72:75], v12, s[12:13] nt
  v_add_u32 v12, 0x2000, v12
  global_load_dwordx4 v[76:79], v12, s[12:13] nt
FETCH:
  s_cmp_lt_u32 s35, 4
  s_cbranch_scc0 QDONE
FETCH2:
  s_load_dwordx16 s[64:79], s[98:99], 0
  s_load_dwordx16 s[80:95], s[98:99], 64
  s_load_dwordx16 s[8:23], s[98:99], 4096
  s_load_dwordx8 s[24:31], s[98:99], 4160
  s_load_dwordx8 s[56:63], s[98:99], 4192
  s_add_u32 s98, s98, 256
  s_addc_u32 s99, s99, 0
  s_lshl_b32 s42, s35, 6
  v_mov_b32 v11, s42
FCHK:
  s_waitcnt lgkmcnt(0)
  s_xor_b64 s[64:65], s[64:65], s[44:45]
  s_xor_b64 s[66:67], s[66:67], s[46:47]
  s_xor_b64 s[68:69], s[68:69], s[44:45]
  s_xor_b64 s[70:71], s[70:71], s[46:47]
  s_xor_b64 s[72:73], s[72:73], s[44:45]
  s_xor_b64 s[74:75], s[74:75], s[46:47]
  s_xor_b64 s[76:77], s[76:77], s[44:45]
  s_xor_b64 s[78:79], s[78:79], s[46:47]
  s_xor_b64 s[80:81], s[80:81], s[44:45]
  s_xor_b64 s[82:83], s[82:83], s[46:47]
  s_xor_b64 s[84:85], s[84:85], s[44:45]
  s_xor_b64 s[86:87], s[86:87], s[46:47]
  s_xor_b64 s[88:89], s[88:89], s[44:45]
  s_xor_b64 s[90:91], s[90:91], s[46:47]
  s_xor_b64 s[92:93], s[92:93], s[44:45]
  s_xor_b64 s[94:95], s[94:95], s[46:47]
  s_xor_b64 s[8:9], s[8:9], s[44:45]
  s_xor_b64 s[10:11], s[10:11], s[46:47]
  s_xor_b64 s[12:13], s[12:13], s[44:45]
  s_xor_b64 s[14:15], s[14:15], s[46:47]
  s_xor_b64 s[16:17], s[16:17], s[44:45]
  s_xor_b64 s[18:19], s[18:19], s[46:47]
  s_xor_b64 s[20:21], s[20:21], s[44:45]
  s_xor_b64 s[22:23], s[22:23], s[46:47]
  s_xor_b64 s[24:25], s[24:25], s[44:45]
  s_xor_b64 s[26:27], s[26:27], s[46:47]
  s_xor_b64 s[28:29], s[28:29], s[44:45]
  s_xor_b64 s[30:31], s[30:31], s[46:47]
  s_xor_b64 s[56:57], s[56:57], s[44:45]
  s_xor_b64 s[58:59], s[58:59], s[46:47]
  s_xor_b64 s[60:61], s[60:61], s[44:45]
  s_xor_b64 s[62:63], s[62:63], s[46:47]
  s_or_b64 s[40:41], s[64:65], s[66:67]
  s_or_b64 s[40:41], s[40:41], s[68:69]
  v_mov_b64 v[32:33], s[64:65]
  s_or_b64 s[40:41], s[40:41], s[70:71]
  v_mov_b64 v[34:35], s[66:67]
  s_or_b64 s[40:41], s[40:41], s[72:73]
  v_mov_b64 v[36:37], s[68:69]
  s_or_b64 s[40:41], s[40:41], s[74:75]
  v_mov_b64 v[38:39], s[70:71]
  s_or_b64 s[40:41], s[40:41], s[76:77]
  v_mov_b64 v[40:41], s[72:73]
  s_or_b64 s[40:41], s[40:41], s[78:79]
  v_mov_b64 v[42:43], s[74:75]
  s_or_b64 s[40:41], s[40:41], s[80:81]
  v_mov_b64 v[44:45], s[76:77]
  s_or_b64 s[40:41], s[40:41], s[82:83]
  v_mov_b64 v[46:47], s[78:79]
  s_or_b64 s[40:41], s[40:41], s[84:85]
  v_mov_b64 v[48:49], s[80:81]
  s_or_b64 s[40:41], s[40:41], s[86:87]
  v_mov_b64 v[50:51], s[82:83]
  s_or_b64 s[40:41], s[40:41], s[88:89]
  v_mov_b64 v[52:53], s[84:85]
  s_or_b64 s[40:41], s[40:41], s[90:91]
  v_mov_b64 v[54:55], s[86:87]
  s_or_b64 s[40:41], s[40:41], s[92:93]
  v_mov_b64 v[56:57], s[88:89]
  s_or_b64 s[40:41], s[40:41], s[94:95]
  v_mov_b64 v[58:59], s[90:91]
  s_or_b64 s[40:41], s[40:41], s[8:9]
  v_mov_b64 v[60:61], s[92:93]
  s_or_b64 s[40:41], s[40:41], s[10:11]
  v_mov_b64 v[62:63], s[94:95]
  s_or_b64 s[40:41], s[40:41], s[12:13]
  v_pk_add_f32 v[32:33], s[8:9], v[32:33]
  s_or_b64 s[40:41], s[40:41], s[14:15]
  v_pk_add_f32 v[34:35], s[10:11], v[34:35]
  s_or_b64 s[40:41], s[40:41], s[16:17]
  v_pk_add_f32 v[36:37], s[12:13], v[36:37]
  s_or_b64 s[40:41], s[40:41], s[18:19]
  v_pk_add_f32 v[38:39], s[14:15], v[38:39]
  s_or_b64 s[40:41], s[40:41], s[20:21]
  v_pk_add_f32 v[40:41], s[16:17], v[40:41]
  s_or_b64 s[40:41], s[40:41], s[22:23]
  v_pk_add_f32 v[42:43], s[18:19], v[42:43]
  s_or_b64 s[40:41], s[40:41], s[24:25]
  v_pk_add_f32 v[44:45], s[20:21], v[44:45]
  s_or_b64 s[40:41], s[40:41], s[26:27]
  v_pk_add_f32 v[46:47], s[22:23], v[46:47]
  s_or_b64 s[40:41], s[40:41], s[28:29]
  v_pk_add_f32 v[48:49], s[24:25], v[48:49]
  s_or_b64 s[40:41], s[40:41], s[30:31]
  v_pk_add_f32 v[50:51], s[26:27], v[50:51]
  s_or_b64 s[40:41], s[40:41], s[56:57]
  v_pk_add_f32 v[52:53], s[28:29], v[52:53]
  s_or_b64 s[40:41], s[40:41], s[58:59]
  v_pk_add_f32 v[54:55], s[30:31], v[54:55]
  s_or_b64 s[40:41], s[40:41], s[60:61]
  v_pk_add_f32 v[56:57], s[56:57], v[56:57]
  s_or_b64 s[40:41], s[40:41], s[62:63]
  v_pk_add_f32 v[58:59], s[58:59], v[58:59]
  s_or_b32 s40, s40, s41
  s_and_b32 s40, s40, 0xff
  s_cbranch_scc0 FOKQ
  s_sub_u32 s49, s49, 1
  s_cbranch_scc1 QFB
  s_sleep 4
  s_load_dwordx16 s[64:79], s[98:99], 0
  s_load_dwordx16 s[80:95], s[98:99], 64
  s_load_dwordx16 s[8:23], s[98:99], 4096
  s_load_dwordx8 s[24:31], s[98:99], 4160
  s_load_dwordx8 s[56:63], s[98:99], 4192
  s_add_u32 s98, s98, 256
  s_addc_u32 s99, s99, 0
  s_branch FCHK
PAD1_0:
  s_cbranch_execz WB1
FOKQ:
  v_pk_add_f32 v[60:61], s[60:61], v[60:61]
  v_pk_add_f32 v[62:63], s[62:63], v[62:63]
  s_mov_b64 exec, 1
  v_cvt_pk_bf16_f32 v32, v32, v33
  v_cvt_pk_bf16_f32 v33, v34, v35
  v_cvt_pk_bf16_f32 v34, v36, v37
  v_cvt_pk_bf16_f32 v35, v38, v39
  ds_write_b128 v11, v[32:35] offset:4352
  v_cvt_pk_bf16_f32 v36, v40, v41
  v_cvt_pk_bf16_f32 v37, v42, v43
  v_cvt_pk_bf16_f32 v38, v44, v45
  v_cvt_pk_bf16_f32 v39, v46, v47
  ds_write_b128 v11, v[36:39] offset:4368
  v_cvt_pk_bf16_f32 v40, v48, v49
  v_cvt_pk_bf16_f32 v41, v50, v51
  v_cvt_pk_bf16_f32 v42, v52, v53
  v_cvt_pk_bf16_f32 v43, v54, v55
  ds_write_b128 v11, v[40:43] offset:4384
  v_cvt_pk_bf16_f32 v44, v56, v57
  v_cvt_pk_bf16_f32 v45, v58, v59
  v_cvt_pk_bf16_f32 v46, v60, v61
  v_cvt_pk_bf16_f32 v47, v62, v63
  ds_write_b128 v11, v[44:47] offset:4400
  s_mov_b64 exec, -1
QDONE:
  v_mov_b32 v63, 0x3fb8aa3b
  v_mov_b32 v52, 0xff800000
  v_mov_b32 v53, 0xff800000
  v_mov_b32 v54, 0xff800000
  v_mov_b32 v55, 0xff800000
  v_mov_b32 v61, 0xff800000
  v_and_b32 v10, 0x70, v9
  v_lshl_add_u32 v10, v2, 7, v10
  s_add_u32 s42, s52, 0x40000
  v_add_u32 v10, s42, v10
  v_add_u32 v11, 0x100000, v10
  s_lshr_b32 s42, s52, 5
  s_add_u32 s42, s42, 0x30000
  v_mov_b32 v16, s42
  v_add_u32 v17, 0x100000, v16
  v_and_b32 v18, 7, v1
  v_lshlrev_b32 v18, 2, v18
  v_and_b32 v19, 8, v1
  v_lshlrev_b32 v19, 1, v19
  s_mov_b32 s40, 0x0f0f0f0f
  s_mov_b32 s41, s40
  s_mov_b32 s42, 0x00ff00ff
  s_mov_b32 s43, s42
  s_cmp_lt_u32 s37, 4
  s_waitcnt lgkmcnt(0)
  v_mov_b32 v36, s34
  v_mov_b32 v37, s34
  v_mov_b32 v38, s34
  v_mov_b32 v39, s34
  s_barrier
  ds_read_b128 v[48:51], v20 offset:4352
  s_cbranch_scc0 QSK
  s_waitcnt vmcnt(3)
QSK:
  s_waitcnt vmcnt(11) lgkmcnt(0)
  s_load_dwordx16 s[8:23], s[0:1], 0
  s_load_dwordx8 s[24:31], s[0:1], 64
  s_cmp_lt_u32 s37, 6
  v_dot2_f32_bf16 v58, v112, v48, 0
  v_dot2_f32_bf16 v59, v116, v48, 0
  v_dot2_f32_bf16 v60, v120, v48, 0
  v_dot2_f32_bf16 v58, v113, v49, v58
  v_dot2_f32_bf16 v59, v117, v49, v59
  v_dot2_f32_bf16 v60, v121, v49, v60
  v_dot2_f32_bf16 v58, v114, v50, v58
  v_dot2_f32_bf16 v59, v118, v50, v59
  v_dot2_f32_bf16 v60, v122, v50, v60
  v_dot2_f32_bf16 v58, v115, v51, v58
  v_dot2_f32_bf16 v59, v119, v51, v59
  v_dot2_f32_bf16 v60, v123, v51, v60
  s_cbranch_scc1 SMX
  s_waitcnt vmcnt(7)
  v_dot2_f32_bf16 v52, v96, v48, 0
  v_dot2_f32_bf16 v53, v100, v48, 0
  v_dot2_f32_bf16 v54, v104, v48, 0
  v_dot2_f32_bf16 v55, v108, v48, 0
  v_dot2_f32_bf16 v52, v97, v49, v52
  v_dot2_f32_bf16 v53, v101, v49, v53
  v_dot2_f32_bf16 v54, v105, v49, v54
  v_dot2_f32_bf16 v55, v109, v49, v55
  v_dot2_f32_bf16 v52, v98, v50, v52
  v_dot2_f32_bf16 v53, v102, v50, v53
  v_dot2_f32_bf16 v54, v106, v50, v54
  v_dot2_f32_bf16 v55, v110, v50, v55
  v_dot2_f32_bf16 v52, v99, v51, v52
  v_dot2_f32_bf16 v53, v103, v51, v53
  v_dot2_f32_bf16 v54, v107, v51, v54
  v_dot2_f32_bf16 v55, v111, v51, v55
SMX:
PAD1_1:
  s_cbranch_execz WB1
  s_nop 1
  v_add_f32_dpp v58, v58, v58 row_ror:8 row_mask:0xf bank_mask:0x3
  v_add_f32_dpp v59, v59, v59 row_ror:8 row_mask:0xf bank_mask:0x3
  v_add_f32_dpp v52, v52, v52 row_ror:8 row_mask:0xf bank_mask:0x3
  v_add_f32_dpp v53, v53, v53 row_ror:8 row_mask:0xf bank_mask:0x3
  v_add_f32_dpp v58, v60, v60 row_ror:8 row_mask:0xf bank_mask:0xc
  v_add_f32_dpp v59, v61, v61 row_ror:8 row_mask:0xf bank_mask:0xc
  v_add_f32_dpp v52, v54, v54 row_ror:8 row_mask:0xf bank_mask:0xc
  v_add_f32_dpp v53, v55, v55 row_ror:8 row_mask:0xf bank_mask:0xc
  v_add_f32_dpp v58, v58, v58 row_shl:4 row_mask:0xf bank_mask:0x5
  v_add_f32_dpp v52, v52, v52 row_shl:4 row_mask:0xf bank_mask:0x5
  s_nop 0
  v_add_f32_dpp v58, v59, v59 row_shr:4 row_mask:0xf bank_mask:0xa
  v_add_f32_dpp v52, v53, v53 row_shr:4 row_mask:0xf bank_mask:0xa
  s_nop 0
  v_add_f32_dpp v58, v58, v58 quad_perm:[1,0,3,2] row_mask:0xf bank_mask:0xf
  v_add_f32_dpp v52, v52, v52 quad_perm:[1,0,3,2] row_mask:0xf bank_mask:0xf
  s_nop 0
  v_add_f32_dpp v58, v58, v58 quad_perm:[2,3,0,1] row_mask:0xf bank_mask:0xf
  v_add_f32_dpp v52, v52, v52 quad_perm:[2,3,0,1] row_mask:0xf bank_mask:0xf
  v_cvt_pk_bf16_f32 v58, 0, v58
  v_cvt_pk_bf16_f32 v52, 0, v52
  v_mul_f32 v58, 0x3db504f3, v58
  v_mul_f32 v52, 0x3db504f3, v52
  v_cvt_pk_bf16_f32 v58, 0, v58
  v_cvt_pk_bf16_f32 v52, 0, v52
  v_max_f32 v54, v52, v58
  s_nop 1
  v_max_f32_dpp v54, v54, v54 row_ror:8 row_mask:0xf bank_mask:0xf
  s_nop 1
  v_max_f32_dpp v54, v54, v54 row_ror:4 row_mask:0xf bank_mask:0xf
  v_mov_b32 v53, v54
  s_nop 1
  v_permlane32_swap_b32 v53, v54
  v_max_f32 v54, v53, v54
  v_mov_b32 v53, v54
  s_nop 1
  v_permlane16_swap_b32 v53, v54
  v_max_f32 v54, v53, v54
  v_sub_f32 v58, v58, v54
  v_sub_f32 v52, v52, v54
  v_mul_f32 v58, v58, v63
  v_mul_f32 v52, v52, v63
  v_exp_f32 v58, v58
  v_exp_f32 v52, v52
  v_cvt_pk_bf16_f32 v57, v58, v58
  v_cvt_pk_bf16_f32 v56, v52, v52
  v_add_f32 v55, v58, v52
  v_and_b32_dpp v112, v57, v4 row_newbcast:0 row_mask:0xf bank_mask:0xf
  v_and_b32_dpp v113, v57, v5 row_newbcast:0 row_mask:0xf bank_mask:0xf
  v_and_b32_dpp v114, v57, v6 row_newbcast:0 row_mask:0xf bank_mask:0xf
  v_and_b32_dpp v115, v57, v7 row_newbcast:0 row_mask:0xf bank_mask:0xf
  v_add_f32_dpp v55, v55, v55 row_ror:8 row_mask:0xf bank_mask:0xf
  v_and_b32_dpp v116, v57, v4 row_newbcast:4 row_mask:0xf bank_mask:0xf
  v_and_b32_dpp v117, v57, v5 row_newbcast:4 row_mask:0xf bank_mask:0xf
  v_and_b32_dpp v118, v57, v6 row_newbcast:4 row_mask:0xf bank_mask:0xf
  v_and_b32_dpp v119, v57, v7 row_newbcast:4 row_mask:0xf bank_mask:0xf
  v_add_f32_dpp v55, v55, v55 row_ror:4 row_mask:0xf bank_mask:0xf
  v_mov_b32 v53, v55
  v_and_b32_dpp v120, v57, v4 row_newbcast:8 row_mask:0xf bank_mask:0xf
  v_and_b32_dpp v121, v57, v5 row_newbcast:8 row_mask:0xf bank_mask:0xf
  v_and_b32_dpp v122, v57, v6 row_newbcast:8 row_mask:0xf bank_mask:0xf
  v_and_b32_dpp v123, v57, v7 row_newbcast:8 row_mask:0xf bank_mask:0xf
  v_permlane32_swap_b32 v53, v55
  v_add_f32 v55, v53, v55
  v_mov_b32 v53, v55
  s_nop 1
  v_permlane16_swap_b32 v53, v55
  v_add_f32 v55, v53, v55
  s_mov_b64 exec, 1
  ds_write2_b32 v21, v54, v55 offset0:0 offset1:8
  s_mov_b64 exec, -1
  s_cmp_lt_u32 s37, 6
  s_cbranch_scc1 NOTA
  v_and_b32_dpp v96, v56, v4 row_newbcast:0 row_mask:0xf bank_mask:0xf
  v_and_b32_dpp v97, v56, v5 row_newbcast:0 row_mask:0xf bank_mask:0xf
  v_and_b32_dpp v98, v56, v6 row_newbcast:0 row_mask:0xf bank_mask:0xf
  v_and_b32_dpp v99, v56, v7 row_newbcast:0 row_mask:0xf bank_mask:0xf
  s_waitcnt vmcnt(6)
  v_mfma_f32_16x16x32_bf16 v[44:47], v[112:115], v[80:83], 0
  v_and_b32_dpp v100, v56, v4 row_newbcast:4 row_mask:0xf bank_mask:0xf
  v_and_b32_dpp v101, v56, v5 row_newbcast:4 row_mask:0xf bank_mask:0xf
  v_and_b32_dpp v102, v56, v6 row_newbcast:4 row_mask:0xf bank_mask:0xf
  v_and_b32_dpp v103, v56, v7 row_newbcast:4 row_mask:0xf bank_mask:0xf
  s_waitcnt vmcnt(5)
  v_mfma_f32_16x16x32_bf16 v[44:47], v[116:119], v[84:87], v[44:47]
  v_and_b32_dpp v104, v56, v4 row_newbcast:8 row_mask:0xf bank_mask:0xf
  v_and_b32_dpp v105, v56, v5 row_newbcast:8 row_mask:0xf bank_mask:0xf
  v_and_b32_dpp v106, v56, v6 row_newbcast:8 row_mask:0xf bank_mask:0xf
  v_and_b32_dpp v107, v56, v7 row_newbcast:8 row_mask:0xf bank_mask:0xf
  s_waitcnt vmcnt(4)
  v_mfma_f32_16x16x32_bf16 v[44:47], v[120:123], v[88:91], v[44:47]
  v_and_b32_dpp v108, v56, v4 row_newbcast:12 row_mask:0xf bank_mask:0xf
  v_and_b32_dpp v109, v56, v5 row_newbcast:12 row_mask:0xf bank_mask:0xf
  v_and_b32_dpp v110, v56, v6 row_newbcast:12 row_mask:0xf bank_mask:0xf
  v_and_b32_dpp v111, v56, v7 row_newbcast:12 row_mask:0xf bank_mask:0xf
  s_waitcnt vmcnt(3)
  v_mfma_f32_16x16x32_bf16 v[44:47], v[96:99], v[64:67], v[44:47]
  s_waitcnt vmcnt(2)
  v_mfma_f32_16x16x32_bf16 v[44:47], v[100:103], v[68:71], v[44:47]
  s_waitcnt vmcnt(1)
  v_mfma_f32_16x16x32_bf16 v[44:47], v[104:107], v[72:75], v[44:47]
  s_waitcnt vmcnt(0)
  v_mfma_f32_16x16x32_bf16 v[44:47], v[108:111], v[76:79], v[44:47]
  s_nop 5
  s_branch PVD
PAD1_2:
  s_cbranch_execz WB1
NOTA:
  s_cmp_lt_u32 s37, 4
  s_cbranch_scc1 LQ2
  s_waitcnt vmcnt(10)
  v_mfma_f32_16x16x32_bf16 v[44:47], v[112:115], v[80:83], 0
  s_waitcnt vmcnt(9)
  v_mfma_f32_16x16x32_bf16 v[44:47], v[116:119], v[84:87], v[44:47]
  s_waitcnt vmcnt(8)
  v_mfma_f32_16x16x32_bf16 v[44:47], v[120:123], v[88:91], v[44:47]
  s_nop 5
  s_branch PVD
LQ2:
  s_waitcnt vmcnt(2)
  v_mfma_f32_16x16x32_bf16 v[44:47], v[112:115], v[80:83], 0
  s_waitcnt vmcnt(1)
  v_mfma_f32_16x16x32_bf16 v[44:47], v[116:119], v[84:87], v[44:47]
  s_waitcnt vmcnt(0)
  v_mfma_f32_16x16x32_bf16 v[44:47], v[120:123], v[88:91], v[44:47]
PVD:
  s_mov_b64 exec, 0xffffffff
  s_nop 6
  ds_write_b128 v14, v[44:47] offset:0
  s_mov_b64 exec, -1
  s_cmp_lg_u32 s35, 7
  s_waitcnt lgkmcnt(0)
  s_barrier
  s_cbranch_scc1 L_LSE
  ds_read_b128 v[40:43], v19 offset:4608
  v_mov_b32 v34, v63
  ds_read_b128 v[48:51], v15 offset:0
  ds_read_b128 v[52:55], v15 offset:512
  ds_read_b128 v[56:59], v15 offset:1024
  ds_read_b128 v[60:63], v15 offset:1536
  s_waitcnt lgkmcnt(4)
  v_max3_f32 v32, v40, v41, v42
  v_max_f32 v32, v32, v43
  s_nop 1
  v_max_f32_dpp v32, v32, v32 row_ror:8 row_mask:0xf bank_mask:0xf
  v_pk_add_f32 v[40:41], v[40:41], v[32:33] op_sel_hi:[1,0] neg_lo:[0,1] neg_hi:[0,1]
  v_pk_add_f32 v[42:43], v[42:43], v[32:33] op_sel_hi:[1,0] neg_lo:[0,1] neg_hi:[0,1]
  v_pk_mul_f32 v[40:41], v[40:41], v[34:35] op_sel_hi:[1,0]
  v_pk_mul_f32 v[42:43], v[42:43], v[34:35] op_sel_hi:[1,0]
  v_exp_f32 v40, v40
  v_exp_f32 v41, v41
  v_exp_f32 v42, v42
  v_exp_f32 v43, v43
  s_waitcnt lgkmcnt(0)
  v_pk_mul_f32 v[48:49], v[48:49], v[40:41] op_sel_hi:[1,0]
  v_pk_mul_f32 v[50:51], v[50:51], v[40:41] op_sel_hi:[1,0]
  v_pk_mul_f32 v[56:57], v[56:57], v[42:43] op_sel_hi:[1,0]
  v_pk_mul_f32 v[58:59], v[58:59], v[42:43] op_sel_hi:[1,0]
  v_pk_fma_f32 v[48:49], v[52:53], v[40:41], v[48:49] op_sel:[0,1,0]
  v_pk_fma_f32 v[50:51], v[54:55], v[40:41], v[50:51] op_sel:[0,1,0]
  v_pk_fma_f32 v[56:57], v[60:61], v[42:43], v[56:57] op_sel:[0,1,0]
  v_pk_fma_f32 v[58:59], v[62:63], v[42:43], v[58:59] op_sel:[0,1,0]
  v_pk_add_f32 v[48:49], v[48:49], v[56:57]
  v_pk_add_f32 v[50:51], v[50:51], v[58:59]
  s_nop 0
  v_add_f32_dpp v48, v48, v48 row_ror:8 row_mask:0xf bank_mask:0xf
  v_add_f32_dpp v49, v49, v49 row_ror:8 row_mask:0xf bank_mask:0xf
  v_add_f32_dpp v50, v50, v50 row_ror:8 row_mask:0xf bank_mask:0xf
  v_add_f32_dpp v51, v51, v51 row_ror:8 row_mask:0xf bank_mask:0xf
  s_mov_b64 exec, s[40:41]
  v_cvt_pk_bf16_f32 v38, v48, v49
  v_cvt_pk_bf16_f32 v39, v50, v51
  s_not_b64 exec, exec
  v_cvt_pk_bf16_f32 v36, v48, v49
  v_cvt_pk_bf16_f32 v37, v50, v51
  s_mov_b64 exec, s[42:43]
  global_store_dwordx4 v10, v[36:39], s[32:33]
  global_store_dwordx4 v11, v[36:39], s[32:33] sc1
  s_mov_b64 exec, -1
  s_branch L_B5
PAD1_3:
  s_cbranch_execz WB1
L_LSE:
  s_cmp_lg_u32 s35, 0
  s_cbranch_scc1 L_B5
  ds_read_b32 v48, v18 offset:4608
  ds_read_b32 v49, v18 offset:4640
  s_waitcnt lgkmcnt(1)
  v_max_f32_dpp v36, v48, v48 quad_perm:[1,0,3,2] row_mask:0xf bank_mask:0xf
  s_nop 1
  v_max_f32_dpp v36, v36, v36 quad_perm:[2,3,0,1] row_mask:0xf bank_mask:0xf
  s_nop 1
  v_max_f32_dpp v36, v36, v36 row_half_mirror row_mask:0xf bank_mask:0xf
  v_sub_f32 v48, v48, v36
  v_mul_f32 v48, v48, v63
  v_exp_f32 v48, v48
  s_waitcnt lgkmcnt(0)
  v_mul_f32 v37, v48, v49
  s_nop 1
  v_add_f32_dpp v37, v37, v37 quad_perm:[1,0,3,2] row_mask:0xf bank_mask:0xf
  s_nop 1
  v_add_f32_dpp v37, v37, v37 quad_perm:[2,3,0,1] row_mask:0xf bank_mask:0xf
  s_nop 1
  v_add_f32_dpp v37, v37, v37 row_half_mirror row_mask:0xf bank_mask:0xf
  s_mov_b64 exec, 1
  global_store_dwordx4 v16, v[36:39], s[32:33]
  global_store_dwordx4 v17, v[36:39], s[32:33] sc1
  s_mov_b64 exec, -1
L_B5:
  s_lshr_b32 s40, s37, 1
  s_cmp_eq_u32 s40, 2
  s_barrier
  s_cbranch_scc0 NOTOP
  s_lshr_b32 s40, s35, 2
  s_and_b32 s41, s35, 3
  s_lshl_b32 s62, s35, 13
  s_add_u32 s62, s62, 16384
  v_and_b32 v26, 1, v2
  v_lshlrev_b32 v24, 2, v26
  v_and_b32 v25, 7, v3
  v_xor_b32 v24, v24, v25
  v_lshrrev_b32 v27, 1, v2
  v_lshl_add_u32 v24, v27, 3, v24
  v_lshlrev_b32 v24, 4, v24
  s_lshl_b32 s42, s38, 1
  s_add_u32 s42, s42, s40
  s_lshl_b32 s43, s42, 8
  s_add_u32 s43, s43, 0x30000
  v_add_u32 v24, s43, v24
  s_lshl_b32 s43, s42, 13
  s_lshl_b32 s42, s41, 7
  s_add_u32 s43, s43, s42
  s_add_u32 s43, s43, 0x40000
  v_lshlrev_b32 v25, 9, v3
  v_lshl_add_u32 v25, v2, 4, v25
  v_add_u32 v25, s43, v25
  v_lshl_add_u32 v27, v26, 1, v27
  v_lshl_add_u32 v27, v27, 4, v3
  v_lshlrev_b32 v27, 2, v27
  s_lshl_b32 s42, s38, 11
  s_and_b32 s43, s39, 7
  s_lshl_b32 s43, s43, 8
  s_add_u32 s42, s42, s43
  s_add_u32 s42, s42, 0xa0000
  s_lshl_b32 s43, s35, 14
  s_add_u32 s42, s42, s43
  v_add_u32 v27, s42, v27
  v_and_b32 v16, 3, v3
  v_lshlrev_b32 v16, 3, v16
  v_lshrrev_b32 v28, v16, s34
  v_lshrrev_b32 v17, 2, v3
  v_lshl_add_u32 v16, v17, 7, v16
  v_mul_u32_u24 v17, 1056, v2
  v_add3_u32 v16, v16, v17, s62
  v_xor_b32 v17, 32, v16
  v_xor_b32 v18, 64, v16
  v_xor_b32 v19, 96, v16
  v_lshlrev_b32 v29, 2, v1
  s_lshl_b32 s42, s35, 8
  v_add_u32 v26, s42, v29
  v_mov_b32 v56, 0
  v_mov_b32 v57, 0
  v_mov_b32 v58, 0
  v_mov_b32 v59, 0
  v_mov_b32 v60, 0
  v_mov_b32 v61, 0
  v_mov_b32 v62, 0
  v_mov_b32 v63, 0
  s_mov_b32 s49, 24
  s_mov_b64 exec, 0
  s_cmp_eq_u32 s35, 0
  s_cbranch_scc1 PAD2_0
  s_cmp_eq_u32 s35, 1
  s_cbranch_scc1 PAD2_1
WB2:
  s_mov_b64 exec, -1
  global_load_dwordx4 v[48:51], v24, s[32:33] sc1
  global_load_dwordx4 v[64:67], v25, s[32:33] sc1
  global_load_dwordx4 v[68:71], v25, s[32:33] offset:64 sc1
  s_waitcnt vmcnt(3)
  ds_read_b64_tr_b16 v[96:97], v16 offset:0
  ds_read_b64_tr_b16 v[98:99], v16 offset:512
  ds_read_b64_tr_b16 v[100:101], v17 offset:0
  ds_read_b64_tr_b16 v[102:103], v17 offset:512
  ds_read_b64_tr_b16 v[104:105], v18 offset:0
  ds_read_b64_tr_b16 v[106:107], v18 offset:512
  ds_read_b64_tr_b16 v[108:109], v19 offset:0
  ds_read_b64_tr_b16 v[110:111], v19 offset:512
  ds_read_b64_tr_b16 v[112:113], v16 offset:4096
  ds_read_b64_tr_b16 v[114:115], v16 offset:4608
  ds_read_b64_tr_b16 v[116:117], v17 offset:4096
  ds_read_b64_tr_b16 v[118:119], v17 offset:4608
  ds_read_b64_tr_b16 v[120:121], v18 offset:4096
  ds_read_b64_tr_b16 v[122:123], v18 offset:4608
  ds_read_b64_tr_b16 v[124:125], v19 offset:4096
  ds_read_b64_tr_b16 v[126:127], v19 offset:4608
  s_branch OCHK
OPOLL:
  s_sub_u32 s49, s49, 1
  s_cmp_lg_u32 s49, 0
  s_cbranch_scc1 OP2
  v_add_u32 v24, 0x100000, v24
  v_add_u32 v25, 0x100000, v25
OP2:
  s_mov_b64 exec, vcc
  global_load_dwordx4 v[48:51], v24, s[32:33] sc1
  s_mov_b64 exec, s[40:41]
  global_load_dwordx4 v[64:67], v25, s[32:33] sc1
  global_load_dwordx4 v[68:71], v25, s[32:33] offset:64 sc1
  s_mov_b64 exec, -1
OCHK:
  s_waitcnt vmcnt(0)
  v_cmp_ne_u32 s[40:41], s34, v64
  v_cmp_ne_u32 s[42:43], s34, v71
  v_cmp_ne_u32 vcc, s34, v51
  v_mov_b32_dpp v56, v66 quad_perm:[0,1,2,3] row_mask:0xf bank_mask:0x3
  v_mov_b32_dpp v57, v67 quad_perm:[0,1,2,3] row_mask:0xf bank_mask:0x3
  v_mov_b32_dpp v58, v68 quad_perm:[0,1,2,3] row_mask:0xf bank_mask:0x3
  v_mov_b32_dpp v59, v69 quad_perm:[0,1,2,3] row_mask:0xf bank_mask:0x3
  s_or_b64 s[40:41], s[40:41], s[42:43]
  s_or_b64 s[42:43], vcc, s[40:41]
  s_cbranch_scc0 OOK
  s_sub_u32 s50, s50, 1
  s_cbranch_scc0 OPOLL
PAD2_0:
  s_cbranch_execz WB2
OOK:
  s_waitcnt lgkmcnt(0)
  v_mfma_f32_16x16x32_bf16 v[80:83], v[56:59], v[96:99], 0
  v_max_f32_dpp v52, v48, v48 quad_perm:[1,0,3,2] row_mask:0xf bank_mask:0xf
  v_mov_b32_dpp v60, v66 quad_perm:[0,1,2,3] row_mask:0xf bank_mask:0xc
  v_mov_b32_dpp v61, v67 quad_perm:[0,1,2,3] row_mask:0xf bank_mask:0xc
  v_mfma_f32_16x16x32_bf16 v[84:87], v[56:59], v[100:103], 0
  v_max_f32_dpp v52, v52, v52 quad_perm:[2,3,0,1] row_mask:0xf bank_mask:0xf
  v_mov_b32_dpp v62, v68 quad_perm:[0,1,2,3] row_mask:0xf bank_mask:0xc
  v_mov_b32_dpp v63, v69 quad_perm:[0,1,2,3] row_mask:0xf bank_mask:0xc
  v_mfma_f32_16x16x32_bf16 v[88:91], v[56:59], v[104:107], 0
  v_max_f32_dpp v52, v52, v52 row_half_mirror row_mask:0xf bank_mask:0xf
  v_sub_f32 v52, v48, v52
  v_mfma_f32_16x16x32_bf16 v[92:95], v[56:59], v[108:111], 0
  v_mul_f32 v52, 0x3fb8aa3b, v52
  v_exp_f32 v52, v52
  v_mfma_f32_16x16x32_bf16 v[80:83], v[60:63], v[112:115], v[80:83]
  v_mul_f32 v53, v52, v49
  v_mfma_f32_16x16x32_bf16 v[84:87], v[60:63], v[116:119], v[84:87]
  v_mov_b32_dpp v72, v52 row_newbcast:0 row_mask:0xf bank_mask:0xf
  v_add_f32_dpp v53, v53, v53 quad_perm:[1,0,3,2] row_mask:0xf bank_mask:0xf
  v_mfma_f32_16x16x32_bf16 v[88:91], v[60:63], v[120:123], v[88:91]
  v_mov_b32_dpp v73, v52 row_newbcast:1 row_mask:0xf bank_mask:0xf
  v_add_f32_dpp v53, v53, v53 quad_perm:[2,3,0,1] row_mask:0xf bank_mask:0xf
  v_mfma_f32_16x16x32_bf16 v[92:95], v[60:63], v[124:127], v[92:95]
  v_mov_b32_dpp v74, v52 row_newbcast:2 row_mask:0xf bank_mask:0xf
  v_add_f32_dpp v53, v53, v53 row_half_mirror row_mask:0xf bank_mask:0xf
  v_mov_b32_dpp v75, v52 row_newbcast:3 row_mask:0xf bank_mask:0xf
  v_rcp_f32 v53, v53
  v_pk_mul_f32 v[32:33], v[80:81], v[72:73]
  v_pk_fma_f32 v[32:33], v[82:83], v[74:75], v[32:33]
  v_add_f32 v40, v32, v33
  v_pk_mul_f32 v[34:35], v[84:85], v[72:73]
  v_pk_fma_f32 v[34:35], v[86:87], v[74:75], v[34:35]
  v_add_f32 v41, v34, v35
  v_pk_mul_f32 v[40:41], v[40:41], v[52:53] op_sel:[0,1]
  v_pk_mul_f32 v[36:37], v[88:89], v[72:73]
  v_pk_fma_f32 v[36:37], v[90:91], v[74:75], v[36:37]
  v_add_f32 v42, v36, v37
  v_permlane32_swap_b32 v40, v41
  v_add_f32 v40, v40, v41
  v_pk_mul_f32 v[38:39], v[92:93], v[72:73]
  v_pk_fma_f32 v[38:39], v[94:95], v[74:75], v[38:39]
  v_add_f32 v43, v38, v39
  v_pk_mul_f32 v[42:43], v[42:43], v[52:53] op_sel:[0,1]
  s_cmp_ge_u32 s35, 8
  s_nop 0
  v_permlane32_swap_b32 v42, v43
  v_add_f32 v42, v42, v43
  s_nop 1
  v_permlane16_swap_b32 v40, v42
  v_add_f32 v40, v40, v42
  ds_write_b32 v26, v40 offset:5120
  s_waitcnt lgkmcnt(0)
  s_barrier
  s_cbranch_scc1 FIN
  ds_read2st64_b32 v[48:49], v29 offset0:20 offset1:21
  ds_read2st64_b32 v[50:51], v29 offset0:22 offset1:23
  ds_read2st64_b32 v[52:53], v29 offset0:24 offset1:25
  ds_read2st64_b32 v[54:55], v29 offset0:26 offset1:27
  s_waitcnt lgkmcnt(2)
  v_pk_add_f32 v[48:49], v[48:49], v[50:51]
  s_waitcnt lgkmcnt(0)
  v_pk_add_f32 v[52:53], v[52:53], v[54:55]
  v_pk_add_f32 v[48:49], v[48:49], v[52:53]
  v_add_f32 v48, v48, v49
  v_bfi_b32 v48, v8, v28, v48
  global_store_dword v27, v48, s[32:33] sc1
FIN:
END:
  s_endpgm
PAD2_1:
  s_cbranch_execz WB2
QFB:
  s_lshl_b32 s40, s36, 10
  s_lshl_b32 s41, s35, 7
  s_add_u32 s40, s40, s41
  s_add_u32 s40, s40, 0x1000
  v_and_b32 v51, 31, v1
  v_lshl_add_u32 v10, v51, 2, s40
  v_and_b32 v50, 3, v3
  v_lshlrev_b32 v50, 3, v50
  v_lshrrev_b32 v50, v50, s34
  v_and_b32 v50, 0xff, v50
  v_lshl_add_u32 v11, v51, 1, v11
QFB1:
  global_load_dword v48, v10, s[32:33] sc1
  global_load_dword v49, v10, s[32:33] offset:512 sc1
  s_waitcnt vmcnt(0)
  v_xor_b32 v48, v48, v50
  v_xor_b32 v49, v49, v50
  v_or_b32 v51, v48, v49
  v_and_b32 v51, 0xff, v51
  v_cmp_ne_u32 vcc, 0, v51
  s_nop 4
  s_cbranch_vccz QFB2
  s_sub_u32 s50, s50, 1
  s_cbranch_scc0 QFB1
QFB2:
  v_add_f32 v48, v48, v49
  v_cvt_pk_bf16_f32 v48, v48, v48
  ds_write_b16 v11, v48 offset:4352
  s_branch QDONE
PAD1_4:
  s_cbranch_execz WB1
NOTOP:
  s_min_u32 s40, s38, 3
  s_mul_i32 s41, s38, 5
  s_add_u32 s40, s40, s41
  s_cmp_lt_u32 s37, 4
  s_cbranch_scc0 NOTQ
  s_cmp_lt_u32 s35, 4
  s_cbranch_scc1 PFW1
  s_cmp_eq_u32 s35, 7
  s_cbranch_scc1 FIN
  s_lshl_b32 s40, s40, 15
  s_mul_i32 s41, s39, 3
  s_add_u32 s41, s41, s35
  s_sub_u32 s41, s41, 4
  s_lshl_b32 s41, s41, 12
  s_add_u32 s40, s40, s41
  s_min_u32 s40, s40, 1404928
  v_lshl_add_u32 v16, v1, 6, s40
  global_load_dword v48, v16, s[24:25]
  s_waitcnt vmcnt(0)
  s_branch FIN
PFW1:
  s_lshl_b32 s41, s39, 2
  s_add_u32 s41, s41, s35
  s_mul_i32 s41, s41, 8*2752
  s_lshl_b32 s40, s40, 6
  s_add_u32 s40, s40, s41
  v_lshrrev_b32 v16, 3, v1
  v_mul_u32_u24 v16, 2752, v16
  v_and_b32 v17, 7, v1
  v_min_u32 v17, 5, v17
  v_lshl_add_u32 v16, v17, 6, v16
  v_add_u32 v16, s40, v16
  v_min_u32 v16, 1409020, v16
  global_load_dword v48, v16, s[20:21]
  s_waitcnt vmcnt(0)
  s_branch FIN
NOTQ:
  s_cmp_lt_u32 s2, 235
  s_cbranch_scc0 FIN
  s_sub_u32 s41, s39, 24
  s_add_u32 s53, s40, s41
  s_lshl_b32 s62, s35, 12
  s_add_u32 s62, s62, 16384
  v_and_b32 v24, 3, v3
  v_lshrrev_b32 v16, 2, v1
  v_lshlrev_b32 v17, 4, v24
  v_lshrrev_b32 v23, 2, v3
  v_lshlrev_b32 v23, 6, v23
  v_lshl_add_u32 v23, v2, 9, v23
  v_lshl_add_u32 v23, v24, 3, v23
  v_add_u32 v23, s62, v23
  s_and_b32 s54, s53, 1
  s_mul_i32 s40, s35, 64*2752
  s_lshl_b32 s41, s53, 6
  s_add_u32 s40, s40, s41
  s_movk_i32 s42, 2752
  v_mad_u32_u24 v16, v16, s42, v17
  s_mul_i32 s41, s54, 32*2752
  s_add_u32 s42, s40, s41
  s_sub_u32 s40, s40, s41
  s_add_u32 s40, s40, 88064
  v_add_u32 v18, s40, v16
  v_add_u32 v16, s42, v16
  v_add_u32 v17, 44032, v16
  v_add_u32 v19, 44032, v18
  s_lshl_b32 s43, s54, 11
  s_add_u32 s62, s62, s43
  s_mov_b32 m0, s62
  s_nop 0
  global_load_lds_dwordx4 v16, s[20:21] nt
  s_xor_b32 m0, s62, 1024
  s_nop 0
  global_load_lds_dwordx4 v17, s[20:21] nt
  s_xor_b32 m0, s62, 2048
  s_nop 0
  global_load_lds_dwordx4 v18, s[20:21] nt
  s_xor_b32 m0, s62, 3072
  s_nop 0
  global_load_lds_dwordx4 v19, s[20:21] nt
  v_lshrrev_b32 v24, 3, v1
  v_and_b32 v25, 7, v1
  v_lshlrev_b32 v26, 12, v24
  v_lshl_add_u32 v26, v25, 4, v26
  s_lshl_b32 s40, s53, 15
  s_lshl_b32 s41, s35, 7
  s_add_u32 s40, s40, s41
  v_add_u32 v26, s40, v26
  global_load_dwordx4 v[112:115], v26, s[24:25] offset:0 nt
  global_load_dwordx4 v[116:119], v26, s[24:25] offset:1024 nt
  global_load_dwordx4 v[120:123], v26, s[24:25] offset:2048 nt
  global_load_dwordx4 v[124:127], v26, s[24:25] offset:3072 nt
  v_sub_u32 v27, 7, v25
  v_min_u32 v27, v27, v25
  v_lshl_add_u32 v27, v24, 2, v27
  s_lshl_b32 s41, s53, 6
  v_lshl_add_u32 v28, v27, 1, s41
  v_lshrrev_b32 v29, 2, v25
  v_lshlrev_b32 v29, 4, v29
  v_lshl_add_u32 v27, v27, 5, v29
  v_lshrrev_b32 v29, 3, v3
  v_lshlrev_b32 v29, 6, v29
  v_lshl_add_u32 v29, v2, 4, v29
  v_and_b32 v30, 1, v3
  v_lshl_add_u32 v29, v30, 3, v29
  v_and_b32 v31, 4, v3
  v_add_u32 v29, v29, v31
  s_lshl_b32 s41, s35, 7
  v_add_u32 v29, s41, v29
  v_lshrrev_b32 v31, 1, v3
  v_lshlrev_b32 v31, 11, v31
  v_lshl_add_u32 v31, v2, 5, v31
  v_lshl_add_u32 v31, v30, 4, v31
  s_lshl_b32 s41, s35, 8
  s_add_u32 s41, s41, 0xa0000
  s_and_b32 s42, s38, 7
  s_lshl_b32 s42, s42, 14
  s_add_u32 s41, s41, s42
  v_add_u32 v31, s41, v31
  global_load_ushort v32, v28, s[22:23]
  global_load_dword v33, v29, s[8:9]
  v_and_b32 v34, 3, v1
  v_lshl_add_u32 v34, v34, 2, v2
  s_and_b32 s41, s53, 31
  s_lshl_b32 s41, s41, 5
  v_lshl_add_u32 v34, v34, 1, s41
  global_load_ushort v35, v34, s[26:27]
  s_lshl_b32 s41, s35, 2
  v_lshl_add_u32 v36, v3, 5, s41
  v_mov_b32 v37, 3328
  v_cmp_gt_u32 vcc, 16, v1
  s_nop 1
  v_cndmask_b32 v36, v37, v36, vcc
  v_lshrrev_b32 v37, 3, v3
  v_lshl_add_u32 v37, v37, 5, s41
  v_and_b32 v38, 3, v1
  v_lshlrev_b32 v38, 4, v38
  v_and_b32 v39, 1, v2
  v_lshlrev_b32 v39, 4, v39
  v_lshl_add_u32 v39, v25, 5, v39
  v_lshrrev_b32 v40, 1, v2
  v_lshl_add_u32 v39, v40, 3, v39
  s_lshl_b32 s40, s53, 11
  s_lshl_b32 s41, s35, 8
  s_add_u32 s40, s40, s41
  s_add_u32 s40, s40, 0x70000
  v_add_u32 v39, s40, v39
  v_lshlrev_b32 v40, 4, v40
  v_lshrrev_b32 v40, v40, s34
  v_lshrrev_b32 v41, 8, v40
  v_lshrrev_b32 v42, 2, v1
  v_lshlrev_b32 v42, 11, v42
  v_add_u32 v42, v42, v38
  s_lshl_b32 s40, s53, 6
  s_add_u32 s40, s40, 0x70000
  v_add_u32 v42, s40, v42
  v_add_u32 v43, 0x8000, v42
  v_add_u32 v44, 0x10000, v42
  v_mov_b32 v48, 0x3f803f80
  v_mov_b32 v49, 0x3f803f80
  v_mov_b32 v50, 0x3f803f80
  v_mov_b32 v51, 0x3f803f80
  s_mov_b64 exec, 0
  s_cmp_eq_u32 s35, 0
  s_cbranch_scc1 PAD4_0
  s_cmp_eq_u32 s35, 1
  s_cbranch_scc1 PAD4_1
  s_cmp_eq_u32 s35, 2
  s_cbranch_scc1 PAD4_2
  s_cmp_eq_u32 s35, 3
  s_cbranch_scc1 PAD4_3
  s_cmp_eq_u32 s35, 4
  s_cbranch_scc1 PAD4_4
WB4:
  s_mov_b64 exec, -1
  s_waitcnt vmcnt(7)
  ds_read_b64_tr_b16 v[96:97], v23 offset:0
  ds_read_b64_tr_b16 v[98:99], v23 offset:2048
  ds_read_b64_tr_b16 v[100:101], v23 offset:32
  ds_read_b64_tr_b16 v[102:103], v23 offset:2080
  ds_read_b64_tr_b16 v[104:105], v23 offset:256
  ds_read_b64_tr_b16 v[106:107], v23 offset:2304
  ds_read_b64_tr_b16 v[108:109], v23 offset:288
  ds_read_b64_tr_b16 v[110:111], v23 offset:2336
  s_waitcnt lgkmcnt(0)
  v_mfma_f32_16x16x32_bf16 v[80:83], v[48:51], v[96:99], 0
  v_mfma_f32_16x16x32_bf16 v[84:87], v[48:51], v[100:103], 0
  v_mfma_f32_16x16x32_bf16 v[80:83], v[48:51], v[104:107], v[80:83]
  v_mfma_f32_16x16x32_bf16 v[84:87], v[48:51], v[108:111], v[84:87]
  s_nop 6
  ds_write_b32 v36, v80 offset:0
  ds_write_b32 v36, v84 offset:512
  s_waitcnt lgkmcnt(0)
  s_barrier
  ds_read_b128 v[52:55], v27 offset:0
  s_waitcnt lgkmcnt(0)
  v_add_f32 v52, v52, v53
  v_add_f32 v54, v54, v55
  v_add_f32 v45, v52, v54
  s_nop 1
  v_add_f32_dpp v45, v45, v45 row_half_mirror row_mask:0xf bank_mask:0xf
  v_mov_b32 v60, 0x3b000000
  s_mov_b64 vcc, -1
HPOLL:
  s_mov_b64 exec, vcc
  global_load_dwordx4 v[12:15], v31, s[32:33] sc1
  global_load_dwordx4 v[16:19], v31, s[32:33] offset:128 sc1
  s_mov_b64 exec, -1
  s_waitcnt vmcnt(0)
  v_xor_b32 v64, s44, v12
  v_xor_b32 v65, s45, v13
  v_xor_b32 v66, s46, v14
  v_xor_b32 v67, s47, v15
  v_xor_b32 v68, s44, v16
  v_xor_b32 v69, s45, v17
  v_xor_b32 v70, s46, v18
  v_xor_b32 v71, s47, v19
  v_or3_b32 v72, v64, v65, v66
  v_or3_b32 v73, v67, v68, v69
  v_or3_b32 v72, v72, v70, v71
  v_or_b32 v72, v72, v73
  v_and_b32 v72, 0xff, v72
  v_cmp_ne_u32 vcc, 0, v72
  v_add_f32_dpp v64, v64, v64 row_ror:8 row_mask:0xf bank_mask:0x3
  v_add_f32_dpp v65, v65, v65 row_ror:8 row_mask:0xf bank_mask:0x3
  v_add_f32_dpp v66, v66, v66 row_ror:8 row_mask:0xf bank_mask:0x3
  v_add_f32_dpp v67, v67, v67 row_ror:8 row_mask:0xf bank_mask:0x3
  s_cbranch_vccz HOK
  s_sub_u32 s50, s50, 1
  s_cbranch_scc0 HPOLL
PAD4_0:
  s_cbranch_execz WB4
HOK:
  v_add_f32_dpp v64, v68, v68 row_ror:8 row_mask:0xf bank_mask:0xc
  v_add_f32_dpp v65, v69, v69 row_ror:8 row_mask:0xf bank_mask:0xc
  v_add_f32_dpp v66, v70, v70 row_ror:8 row_mask:0xf bank_mask:0xc
  v_add_f32_dpp v67, v71, v71 row_ror:8 row_mask:0xf bank_mask:0xc
  v_add_f32_dpp v64, v64, v64 row_shl:4 row_mask:0xf bank_mask:0x5
  v_add_f32_dpp v65, v65, v65 row_shl:4 row_mask:0xf bank_mask:0x5
  s_nop 0
  v_add_f32_dpp v64, v66, v66 row_shr:4 row_mask:0xf bank_mask:0xa
  v_add_f32_dpp v65, v67, v67 row_shr:4 row_mask:0xf bank_mask:0xa
  v_lshlrev_b32 v46, 16, v33
  v_add_f32_dpp v64, v64, v64 quad_perm:[2,3,0,1] row_mask:0xf bank_mask:0xf
  v_add_f32_dpp v65, v65, v65 quad_perm:[2,3,0,1] row_mask:0xf bank_mask:0xf
  v_and_b32 v47, s48, v33
  v_cvt_pk_bf16_f32 v64, 0, v64
  v_cvt_pk_bf16_f32 v65, 0, v65
  v_pk_add_f32 v[64:65], v[64:65], v[46:47]
  v_cvt_pk_bf16_f32 v72, v64, v65
  ds_write_b32 v29, v72 offset:7424
  v_dot2_f32_bf16 v64, v72, v48, 0
  v_mov_b32_dpp v73, v72 row_ror:12 row_mask:0xf bank_mask:0xf
  v_mov_b32_dpp v74, v72 row_ror:8 row_mask:0xf bank_mask:0xf
  v_mov_b32_dpp v75, v72 row_ror:4 row_mask:0xf bank_mask:0xf
  v_dot2_f32_bf16 v65, v72, v72, 0
  s_nop 0
  v_mfma_f32_16x16x32_bf16 v[80:83], v[72:75], v[96:99], 0
  v_add_f32_dpp v64, v64, v64 row_ror:8 row_mask:0xf bank_mask:0x3
  v_lshlrev_b32 v32, 16, v32
  s_nop 0
  v_add_f32_dpp v64, v65, v65 row_ror:8 row_mask:0xf bank_mask:0xc
  v_mfma_f32_16x16x32_bf16 v[88:91], v[72:75], v[104:107], 0
  s_nop 0
  v_add_f32_dpp v64, v64, v64 row_half_mirror row_mask:0xf bank_mask:0xf
  v_mfma_f32_16x16x32_bf16 v[84:87], v[72:75], v[100:103], 0
  s_nop 0
  v_add_f32_dpp v64, v64, v64 quad_perm:[1,0,3,2] row_mask:0xf bank_mask:0xf
  v_mov_b32 v65, v64
  v_mfma_f32_16x16x32_bf16 v[92:95], v[72:75], v[108:111], 0
  s_nop 0
  v_permlane32_swap_b32 v64, v65
  v_add_f32 v64, v64, v65
  v_mov_b32 v65, v64
  v_add_f32 v80, v80, v89
  s_nop 0
  v_permlane16_swap_b32 v64, v65
  v_add_f32 v64, v64, v65
  ds_write_b32 v36, v80 offset:5120
  ds_write_b32 v37, v64 offset:7168
  v_add_f32 v84, v84, v93
  ds_write_b32 v36, v84 offset:5632
  s_waitcnt lgkmcnt(0)
PAD4_1:
  s_cbranch_execz WB4
  s_barrier
  ds_read_b128 v[56:59], v38 offset:7168
  ds_read_b128 v[52:55], v27 offset:5120
  ds_read_u16 v61, v34 offset:7424
  s_waitcnt lgkmcnt(2)
  v_pk_add_f32 v[56:57], v[56:57], v[58:59]
  v_add_f32 v56, v56, v57
  s_waitcnt lgkmcnt(1)
  v_pk_add_f32 v[52:53], v[52:53], v[54:55]
  v_add_f32_dpp v56, v56, v56 quad_perm:[1,0,3,2] row_mask:0xf bank_mask:0xf
  v_add_f32 v52, v52, v53
  s_nop 0
  v_mul_f32_dpp v57, v56, v60 quad_perm:[0,0,0,0] row_mask:0xf bank_mask:0xf
  v_mul_f32_dpp v58, v56, v60 quad_perm:[2,2,2,2] row_mask:0xf bank_mask:0xf
  v_fma_f32 v58, -v57, v57, v58
  v_max_f32 v58, 0, v58
  v_cvt_pk_bf16_f32 v58, 0, v58
  v_add_f32_dpp v52, v52, v52 row_half_mirror row_mask:0xf bank_mask:0xf
  v_add_f32 v58, 0x3727c5ac, v58
  v_cvt_pk_bf16_f32 v58, 0, v58
  v_sqrt_f32 v58, v58
  v_cvt_pk_bf16_f32 v57, 0, v57
  v_cvt_pk_bf16_f32 v58, 0, v58
  v_rcp_f32 v58, v58
  v_fma_f32 v52, -v57, v45, v52
  v_mul_f32 v52, v52, v58
  v_cvt_pk_bf16_f32 v52, 0, v52
  v_add_f32 v52, v52, v32
  v_cvt_pk_bf16_f32 v52, 0, v52
  v_max_f32 v52, 0, v52
  v_mul_f32 v52, v52, v52
  v_cvt_pk_bf16_f32 v52, v52, v52
PAD4_2:
  s_cbranch_execz WB4
  s_mov_b32 s40, 0x00ff00ff
  s_mov_b32 s41, s40
  v_and_b32_dpp v64, v52, v4 quad_perm:[0,0,0,0] row_mask:0xf bank_mask:0xf
  v_and_b32_dpp v65, v52, v5 quad_perm:[0,0,0,0] row_mask:0xf bank_mask:0xf
  v_and_b32_dpp v66, v52, v6 quad_perm:[3,3,3,3] row_mask:0xf bank_mask:0xf
  v_and_b32_dpp v67, v52, v7 quad_perm:[3,3,3,3] row_mask:0xf bank_mask:0xf
  v_and_b32_dpp v68, v52, v4 quad_perm:[1,1,1,1] row_mask:0xf bank_mask:0xf
  v_and_b32_dpp v69, v52, v5 quad_perm:[1,1,1,1] row_mask:0xf bank_mask:0xf
  v_and_b32_dpp v70, v52, v6 quad_perm:[2,2,2,2] row_mask:0xf bank_mask:0xf
  v_and_b32_dpp v71, v52, v7 quad_perm:[2,2,2,2] row_mask:0xf bank_mask:0xf
  v_mfma_f32_16x16x32_bf16 v[80:83], v[64:67], v[112:115], 0
  v_and_b32_dpp v72, v52, v4 quad_perm:[2,2,2,2] row_mask:0xf bank_mask:0xf
  v_and_b32_dpp v73, v52, v5 quad_perm:[2,2,2,2] row_mask:0xf bank_mask:0xf
  v_and_b32_dpp v74, v52, v6 quad_perm:[1,1,1,1] row_mask:0xf bank_mask:0xf
  v_and_b32_dpp v75, v52, v7 quad_perm:[1,1,1,1] row_mask:0xf bank_mask:0xf
  v_mfma_f32_16x16x32_bf16 v[80:83], v[68:71], v[116:119], v[80:83]
  v_and_b32_dpp v76, v52, v4 quad_perm:[3,3,3,3] row_mask:0xf bank_mask:0xf
  v_and_b32_dpp v77, v52, v5 quad_perm:[3,3,3,3] row_mask:0xf bank_mask:0xf
  v_and_b32_dpp v78, v52, v6 quad_perm:[0,0,0,0] row_mask:0xf bank_mask:0xf
  v_and_b32_dpp v79, v52, v7 quad_perm:[0,0,0,0] row_mask:0xf bank_mask:0xf
  v_mfma_f32_16x16x32_bf16 v[80:83], v[72:75], v[120:123], v[80:83]
  s_nop 0
  v_mfma_f32_16x16x32_bf16 v[80:83], v[76:79], v[124:127], v[80:83]
  s_nop 7
  v_permlane32_swap_b32 v80, v82
  v_permlane32_swap_b32 v81, v83
  s_nop 0
  v_add_f32_dpp v80, v82, v80 row_ror:8 row_mask:0xf bank_mask:0xf
  v_add_f32_dpp v81, v83, v81 row_ror:8 row_mask:0xf bank_mask:0xf
  v_bfi_b32 v80, v8, v40, v80
  v_bfi_b32 v81, v8, v41, v81
  s_mov_b64 exec, s[40:41]
  global_store_dwordx2 v39, v[80:81], s[32:33] sc1
  s_mov_b64 exec, -1
  s_cmp_lg_u32 s35, 0
  s_cbranch_scc1 FIN
  s_cmp_ge_u32 s53, 32
  s_cbranch_scc1 FFIN
  s_waitcnt lgkmcnt(0)
  v_lshlrev_b32 v61, 16, v61
  v_lshlrev_b32 v35, 16, v35
  s_mov_b32 s42, -1
  s_mov_b32 s43, 0xfff
  s_mov_b64 vcc, -1
  v_mov_b32 v104, s44
  v_mov_b32 v105, s45
  v_mov_b32 v106, s46
  v_mov_b32 v107, s47
PAD4_3:
  s_cbranch_execz WB4
  s_waitcnt vmcnt(0)
FPOLL:
  s_mov_b64 exec, vcc
  global_load_dwordx4 v[96:99], v42, s[32:33] sc1
  global_load_dwordx4 v[100:103], v43, s[32:33] sc1
  s_and_b64 exec, exec, s[42:43]
  global_load_dwordx4 v[104:107], v44, s[32:33] sc1
  s_mov_b64 exec, -1
  s_waitcnt vmcnt(0)
  v_xor_b32 v64, s44, v96
  v_xor_b32 v65, s45, v97
  v_xor_b32 v66, s46, v98
  v_xor_b32 v67, s47, v99
  v_xor_b32 v68, s44, v100
  v_xor_b32 v69, s45, v101
  v_xor_b32 v70, s46, v102
  v_xor_b32 v71, s47, v103
  v_xor_b32 v72, s44, v104
  v_xor_b32 v73, s45, v105
  v_xor_b32 v74, s46, v106
  v_xor_b32 v75, s47, v107
  v_or3_b32 v76, v64, v65, v66
  v_or3_b32 v77, v67, v68, v69
  v_or3_b32 v76, v76, v70, v71
  v_or3_b32 v77, v77, v72, v73
  v_or3_b32 v76, v76, v74, v75
  v_or_b32 v76, v76, v77
  v_and_b32 v76, 0xff, v76
  v_cmp_ne_u32 vcc, 0, v76
  v_pk_add_f32 v[64:65], v[64:65], v[68:69]
  v_pk_add_f32 v[66:67], v[66:67], v[70:71]
  v_pk_add_f32 v[64:65], v[64:65], v[72:73]
  v_pk_add_f32 v[66:67], v[66:67], v[74:75]
  s_cbranch_vccz FOK
  s_sub_u32 s50, s50, 1
  s_cbranch_scc0 FPOLL
PAD4_4:
  s_cbranch_execz WB4
FOK:
  v_permlane32_swap_b32 v64, v66
  v_permlane32_swap_b32 v65, v67
  v_pk_add_f32 v[64:65], v[64:65], v[66:67]
  s_mov_b32 s40, 0x000f000f
  s_mov_b32 s41, s40
  v_permlane16_swap_b32 v64, v65
  v_add_f32 v64, v64, v65
  s_nop 1
  v_add_f32_dpp v64, v64, v64 row_ror:8 row_mask:0xf bank_mask:0xf
  s_nop 1
  v_add_f32_dpp v64, v64, v64 row_ror:4 row_mask:0xf bank_mask:0xf
  v_cvt_pk_bf16_f32 v64, 0, v64
  v_add_f32 v64, v64, v35
  v_cvt_pk_bf16_f32 v64, 0, v64
  v_add_f32 v64, v64, v61
  v_cvt_pk_bf16_f32 v64, v64, v64
  s_mov_b64 exec, s[40:41]
  global_store_short v34, v64, s[28:29]
  s_cmp_lg_u32 s53, 0
  s_cbranch_scc1 FFIN
  s_mov_b64 exec, 1
  v_mov_b32 v65, 0
  v_mov_b32 v66, s34
  global_store_dword v65, v66, s[32:33]
FFIN:
  s_branch FIN
.fill 700, 4, 0xbf810000
.section .rodata,"a"
.p2align 6
.amdhsa_kernel sequential_preLN__sliding_block_cached__dense_activation_squared_relu__decode_kernel
  .amdhsa_next_free_vgpr 128
  .amdhsa_next_free_sgpr 102
  .amdhsa_accum_offset 128
  .amdhsa_group_segment_fixed_size 0
  .amdhsa_kernarg_size 104
  .amdhsa_user_sgpr_count 2
  .amdhsa_user_sgpr_kernarg_segment_ptr 1
  .amdhsa_system_sgpr_workgroup_id_x 1
  .amdhsa_float_denorm_mode_32 3
.end_amdhsa_kernel
```
